```python
import torch

def _softmax(x, axis=-1):
    return torch.softmax(x, dim=axis)
def _gelu(x):
    return torch.nn.functional.gelu(x, approximate="tanh")
def _silu(x):
    return torch.nn.functional.silu(x)
def _sigmoid(x):
    return torch.sigmoid(x)
def _layernorm(x, axis=-1, eps=1e-5):
    m = x.mean(dim=axis, keepdim=True)
    v = x.var(dim=axis, keepdim=True, unbiased=False)
    return (x - m) / torch.sqrt(v + eps)
def _scatter_add(tgt, idx, src, axis=0):
    return tgt.clone().index_add_(axis, idx, src)
def _segment_sum(src, seg, n):
    out = torch.zeros((n,) + src.shape[1:], dtype=src.dtype)
    return out.index_add_(0, seg, src)
def _pad(x, pw):
    flat = tuple(v for pair in reversed(pw) for v in pair)
    return torch.nn.functional.pad(x, flat)

kernel_name = 'standalone__gqa_softmax__sampling'

def setup_inputs():

    _w = (lambda a: (lambda t: t.to(torch.bfloat16) if t.is_floating_point() else t)(torch.as_tensor(a)))
    B, Hq, Hkv, Sq, Sk, D = 8, 32, 8, 4, 8192, 128
    return {
        "q": _w((lambda *s: torch.randn(*s, dtype=torch.bfloat16) * 0.8)(B, Hq, Sq, D)),
        "k": _w((lambda *s: torch.randn(*s, dtype=torch.bfloat16) * 0.8)(B, Hkv, Sk, D)),
        "v": _w((lambda *s: torch.randn(*s, dtype=torch.bfloat16) * 0.05)(B, Hkv, Sk, D)),
    }

def reference(q, k, v):
    B, Hq, Sq, D = q.shape
    Hkv = k.shape[1]
    rep = Hq // Hkv
    k = (lambda x, n, axis: torch.repeat_interleave(x, n, dim=axis))(k, rep, axis=1)
    v = (lambda x, n, axis: torch.repeat_interleave(x, n, dim=axis))(v, rep, axis=1)
    scale = D ** -0.5
    scores = torch.einsum("bhqd,bhkd->bhqk", q, k) * scale
    p = _softmax(scores, axis=-1)
    return torch.einsum("bhqk,bhkd->bhqd", p, v)
```

```asm
; @launch grid=(256,1,1) block=(320,1,1) lds=140352
.amdgcn_target "amdgcn-amd-amdhsa--gfx950"
.text
.globl standalone__gqa_softmax__sampling_kernel
.p2align 8
.type standalone__gqa_softmax__sampling_kernel,@function
standalone__gqa_softmax__sampling_kernel:
    s_cmp_ge_u32 s2, 256
    s_cbranch_scc1 L_end
    s_load_dwordx4 s[4:7], s[0:1], 0
    s_load_dwordx4 s[8:11], s[0:1], 16
    s_load_dwordx4 s[12:15], s[0:1], 32
    v_lshrrev_b32 v2, 6, v0
    v_and_b32 v1, 63, v0
    v_readfirstlane_b32 s40, v2
    s_and_b32 s41, s2, 7
    s_lshr_b32 s48, s2, 5
    s_lshl_b32 s41, s41, 3
    s_or_b32 s41, s41, s48
    s_bfe_u32 s42, s2, 0x20003
    v_lshrrev_b32 v2, 4, v1
    v_and_b32 v3, 15, v1
    s_cmp_lg_u32 s40, 0
    s_cbranch_scc1 L_consumer
    v_xor_b32 v10, v3, v2
    v_lshlrev_b32 v10, 4, v10
    v_lshl_add_u32 v4, v2, 8, v10
    s_lshl_b32 s48, s41, 21
    s_mov_b32 s18, 0x200000
    s_mov_b32 s19, 0x20000
    s_lshl_b32 s53, s42, 14
    v_xor_b32 v5, 64, v4
    v_xor_b32 v6, 128, v4
    v_xor_b32 v7, 192, v4
    v_lshlrev_b32 v10, 1, v2
    v_xor_b32 v10, v3, v10
    v_lshlrev_b32 v10, 4, v10
    v_lshl_add_u32 v8, v2, 8, v10
    v_xor_b32 v9, 128, v8
    s_mov_b32 s22, 0x200000
    s_mov_b32 s23, 0x20000
    s_mul_i32 s55, s41, 3
    s_lshr_b32 s50, s41, 5
    s_mul_i32 s50, s50, 16
    s_add_u32 s55, s55, s50
    s_and_b32 s55, s55, 31
    s_lshl_b32 s44, s55, 16
    s_or_b32 s44, s44, s53
    s_cmp_eq_u32 s42, 3
    s_cselect_b32 s51, 18, -1
    s_mov_b32 s47, 0
    s_setprio 1
    s_waitcnt lgkmcnt(0)
    s_add_u32 s16, s6, s48
    s_addc_u32 s17, s7, 0
    s_add_u32 s20, s8, s48
    s_addc_u32 s21, s9, 0
    s_mov_b32 s43, 0
L_load0:
    s_add_u32 m0, s47, 0
    s_add_u32 s45, s44, 0
    s_waitcnt vmcnt(31)
    buffer_load_dwordx4 v4, s[16:19], s45 offen offset:0 nt lds
    s_waitcnt vmcnt(31)
    buffer_load_dwordx4 v5, s[16:19], s45 offen offset:1024 nt lds
    s_waitcnt vmcnt(31)
    buffer_load_dwordx4 v6, s[16:19], s45 offen offset:2048 nt lds
    s_waitcnt vmcnt(31)
    buffer_load_dwordx4 v7, s[16:19], s45 offen offset:3072 nt lds
    s_add_u32 m0, s47, 4096
    s_add_u32 s45, s44, 4096
    s_waitcnt vmcnt(31)
    buffer_load_dwordx4 v4, s[16:19], s45 offen offset:0 nt lds
    s_waitcnt vmcnt(31)
    buffer_load_dwordx4 v5, s[16:19], s45 offen offset:1024 nt lds
    s_waitcnt vmcnt(31)
    buffer_load_dwordx4 v6, s[16:19], s45 offen offset:2048 nt lds
    s_waitcnt vmcnt(31)
    buffer_load_dwordx4 v7, s[16:19], s45 offen offset:3072 nt lds
    s_add_u32 m0, s47, 8192
    s_add_u32 s45, s44, 8192
    s_waitcnt vmcnt(31)
    buffer_load_dwordx4 v4, s[16:19], s45 offen offset:0 nt lds
    s_waitcnt vmcnt(31)
    buffer_load_dwordx4 v5, s[16:19], s45 offen offset:1024 nt lds
    s_waitcnt vmcnt(31)
    buffer_load_dwordx4 v6, s[16:19], s45 offen offset:2048 nt lds
    s_waitcnt vmcnt(31)
    buffer_load_dwordx4 v7, s[16:19], s45 offen offset:3072 nt lds
    s_add_u32 m0, s47, 12288
    s_add_u32 s45, s44, 12288
    s_waitcnt vmcnt(31)
    buffer_load_dwordx4 v4, s[16:19], s45 offen offset:0 nt lds
    s_waitcnt vmcnt(31)
    buffer_load_dwordx4 v5, s[16:19], s45 offen offset:1024 nt lds
    s_waitcnt vmcnt(31)
    buffer_load_dwordx4 v6, s[16:19], s45 offen offset:2048 nt lds
    s_waitcnt vmcnt(31)
    s_cmp_lt_u32 s43, 2
    s_cbranch_scc1 L_nobar
    s_barrier
L_nobar:
    buffer_load_dwordx4 v7, s[16:19], s45 offen offset:3072 nt lds
    s_add_u32 s47, s47, 16384
    s_and_b32 s47, s47, 131071
    s_add_u32 s55, s55, 1
    s_and_b32 s55, s55, 31
    s_lshl_b32 s44, s55, 16
    s_or_b32 s44, s44, s53
    s_add_u32 s43, s43, 1
    s_cmp_lt_u32 s43, 2
    s_cbranch_scc1 L_load0
L_load1:
    s_add_u32 m0, s47, 0
    s_add_u32 s45, s44, 0
    s_waitcnt vmcnt(18)
    buffer_load_dwordx4 v4, s[16:19], s45 offen offset:0 nt lds
    s_waitcnt vmcnt(18)
    buffer_load_dwordx4 v5, s[16:19], s45 offen offset:1024 nt lds
    s_waitcnt vmcnt(18)
    s_barrier
    buffer_load_dwordx4 v6, s[16:19], s45 offen offset:2048 nt lds
    s_waitcnt vmcnt(18)
    buffer_load_dwordx4 v7, s[16:19], s45 offen offset:3072 nt lds
    s_add_u32 m0, s47, 4096
    s_add_u32 s45, s44, 4096
    s_waitcnt vmcnt(18)
    buffer_load_dwordx4 v4, s[16:19], s45 offen offset:0 nt lds
    s_waitcnt vmcnt(18)
    buffer_load_dwordx4 v5, s[16:19], s45 offen offset:1024 nt lds
    s_waitcnt vmcnt(18)
    buffer_load_dwordx4 v6, s[16:19], s45 offen offset:2048 nt lds
    s_waitcnt vmcnt(18)
    buffer_load_dwordx4 v7, s[16:19], s45 offen offset:3072 nt lds
    s_add_u32 m0, s47, 8192
    s_add_u32 s45, s44, 8192
    s_waitcnt vmcnt(18)
    buffer_load_dwordx4 v4, s[16:19], s45 offen offset:0 nt lds
    s_waitcnt vmcnt(18)
    buffer_load_dwordx4 v5, s[16:19], s45 offen offset:1024 nt lds
    s_waitcnt vmcnt(18)
    buffer_load_dwordx4 v6, s[16:19], s45 offen offset:2048 nt lds
    s_waitcnt vmcnt(18)
    buffer_load_dwordx4 v7, s[16:19], s45 offen offset:3072 nt lds
    s_add_u32 m0, s47, 12288
    s_add_u32 s45, s44, 12288
    s_waitcnt vmcnt(18)
    buffer_load_dwordx4 v4, s[16:19], s45 offen offset:0 nt lds
    s_waitcnt vmcnt(18)
    buffer_load_dwordx4 v5, s[16:19], s45 offen offset:1024 nt lds
    s_waitcnt vmcnt(18)
    buffer_load_dwordx4 v6, s[16:19], s45 offen offset:2048 nt lds
    s_waitcnt vmcnt(18)
    buffer_load_dwordx4 v7, s[16:19], s45 offen offset:3072 nt lds
    s_add_u32 s47, s47, 16384
    s_and_b32 s47, s47, 131071
    s_add_u32 s55, s55, 1
    s_and_b32 s55, s55, 31
    s_lshl_b32 s44, s55, 16
    s_or_b32 s44, s44, s53
    s_cmp_lg_u32 s43, s51
    s_cbranch_scc1 L_nopub
    s_lshl_b32 s48, s41, 2
    s_add_u32 s12, s12, s48
    s_addc_u32 s13, s13, 0
    s_getreg_b32 s49, hwreg(HW_REG_XCC_ID, 0, 4)
    s_or_b32 s49, s49, 0x80
    s_atomic_add s49, s[12:13], 0 glc
L_nopub:
    s_add_u32 s43, s43, 1
    s_cmp_lt_u32 s43, 32
    s_cbranch_scc1 L_load1
    s_mov_b32 s43, 0
L_load2:
    s_add_u32 m0, s47, 0
    s_add_u32 s45, s44, 0
    s_waitcnt vmcnt(18)
    buffer_load_dwordx4 v8, s[20:23], s45 offen offset:0 nt lds
    s_waitcnt vmcnt(18)
    buffer_load_dwordx4 v9, s[20:23], s45 offen offset:1024 nt lds
    s_waitcnt vmcnt(18)
    s_barrier
    buffer_load_dwordx4 v8, s[20:23], s45 offen offset:2048 nt lds
    s_waitcnt vmcnt(18)
    buffer_load_dwordx4 v9, s[20:23], s45 offen offset:3072 nt lds
    s_add_u32 m0, s47, 4096
    s_add_u32 s45, s44, 4096
    s_waitcnt vmcnt(18)
    buffer_load_dwordx4 v8, s[20:23], s45 offen offset:0 nt lds
    s_waitcnt vmcnt(18)
    buffer_load_dwordx4 v9, s[20:23], s45 offen offset:1024 nt lds
    s_waitcnt vmcnt(18)
    buffer_load_dwordx4 v8, s[20:23], s45 offen offset:2048 nt lds
    s_waitcnt vmcnt(18)
    buffer_load_dwordx4 v9, s[20:23], s45 offen offset:3072 nt lds
    s_add_u32 m0, s47, 8192
    s_add_u32 s45, s44, 8192
    s_waitcnt vmcnt(18)
    buffer_load_dwordx4 v8, s[20:23], s45 offen offset:0 nt lds
    s_waitcnt vmcnt(18)
    buffer_load_dwordx4 v9, s[20:23], s45 offen offset:1024 nt lds
    s_waitcnt vmcnt(18)
    buffer_load_dwordx4 v8, s[20:23], s45 offen offset:2048 nt lds
    s_waitcnt vmcnt(18)
    buffer_load_dwordx4 v9, s[20:23], s45 offen offset:3072 nt lds
    s_add_u32 m0, s47, 12288
    s_add_u32 s45, s44, 12288
    s_waitcnt vmcnt(18)
    buffer_load_dwordx4 v8, s[20:23], s45 offen offset:0 nt lds
    s_waitcnt vmcnt(18)
    buffer_load_dwordx4 v9, s[20:23], s45 offen offset:1024 nt lds
    s_waitcnt vmcnt(18)
    buffer_load_dwordx4 v8, s[20:23], s45 offen offset:2048 nt lds
    s_waitcnt vmcnt(18)
    buffer_load_dwordx4 v9, s[20:23], s45 offen offset:3072 nt lds
    s_add_u32 s47, s47, 16384
    s_and_b32 s47, s47, 131071
    s_add_u32 s55, s55, 1
    s_and_b32 s55, s55, 31
    s_lshl_b32 s44, s55, 16
    s_or_b32 s44, s44, s53
    s_add_u32 s43, s43, 1
    s_cmp_lt_u32 s43, 28
    s_cbranch_scc1 L_load2
L_load3:
    s_add_u32 m0, s47, 0
    s_add_u32 s45, s44, 0
    s_waitcnt vmcnt(31)
    buffer_load_dwordx4 v8, s[20:23], s45 offen offset:0 nt lds
    s_waitcnt vmcnt(31)
    buffer_load_dwordx4 v9, s[20:23], s45 offen offset:1024 nt lds
    s_waitcnt vmcnt(31)
    buffer_load_dwordx4 v8, s[20:23], s45 offen offset:2048 nt lds
    s_waitcnt vmcnt(31)
    buffer_load_dwordx4 v9, s[20:23], s45 offen offset:3072 nt lds
    s_add_u32 m0, s47, 4096
    s_add_u32 s45, s44, 4096
    s_waitcnt vmcnt(31)
    buffer_load_dwordx4 v8, s[20:23], s45 offen offset:0 nt lds
    s_waitcnt vmcnt(31)
    buffer_load_dwordx4 v9, s[20:23], s45 offen offset:1024 nt lds
    s_waitcnt vmcnt(31)
    buffer_load_dwordx4 v8, s[20:23], s45 offen offset:2048 nt lds
    s_waitcnt vmcnt(31)
    buffer_load_dwordx4 v9, s[20:23], s45 offen offset:3072 nt lds
    s_add_u32 m0, s47, 8192
    s_add_u32 s45, s44, 8192
    s_waitcnt vmcnt(31)
    buffer_load_dwordx4 v8, s[20:23], s45 offen offset:0 nt lds
    s_waitcnt vmcnt(31)
    buffer_load_dwordx4 v9, s[20:23], s45 offen offset:1024 nt lds
    s_waitcnt vmcnt(31)
    buffer_load_dwordx4 v8, s[20:23], s45 offen offset:2048 nt lds
    s_waitcnt vmcnt(31)
    buffer_load_dwordx4 v9, s[20:23], s45 offen offset:3072 nt lds
    s_add_u32 m0, s47, 12288
    s_add_u32 s45, s44, 12288
    s_waitcnt vmcnt(31)
    buffer_load_dwordx4 v8, s[20:23], s45 offen offset:0 nt lds
    s_waitcnt vmcnt(31)
    buffer_load_dwordx4 v9, s[20:23], s45 offen offset:1024 nt lds
    s_waitcnt vmcnt(31)
    buffer_load_dwordx4 v8, s[20:23], s45 offen offset:2048 nt lds
    s_waitcnt vmcnt(31)
    s_barrier
    buffer_load_dwordx4 v9, s[20:23], s45 offen offset:3072 nt lds
    s_add_u32 s47, s47, 16384
    s_and_b32 s47, s47, 131071
    s_add_u32 s55, s55, 1
    s_and_b32 s55, s55, 31
    s_lshl_b32 s44, s55, 16
    s_or_b32 s44, s44, s53
    s_add_u32 s43, s43, 1
    s_cmp_lt_u32 s43, 32
    s_cbranch_scc1 L_load3
    s_waitcnt vmcnt(16) lgkmcnt(0)
    s_barrier
    s_waitcnt vmcnt(0)
    s_barrier
    s_endpgm
L_consumer:
    s_sub_u32 s40, s40, 1
    v_lshlrev_b32 v14, 4, v2
    v_lshl_add_u32 v14, v3, 8, v14
    s_lshl_b32 s49, s41, 12
    s_mov_b32 s48, 0
    s_mov_b32 s26, 0x1000
    s_mov_b32 s27, 0x20000
    s_mov_b32 s30, 0x800000
    s_mov_b32 s31, 0x20000
    s_mov_b32 s34, 0x1000
    s_mov_b32 s35, 0x20000
    s_mul_i32 s50, s40, 1536
    v_lshl_add_u32 v15, v1, 4, s50
    v_lshl_add_u32 v16, v1, 3, s50
    s_mov_b32 s56, 0x80008000
    v_mov_b32 v100, s56
    v_mov_b32 v101, s56
    v_mov_b32 v102, s56
    v_mov_b32 v103, s56
    s_mul_i32 s44, s41, 3
    s_add_u32 s44, s44, s42
    s_mul_i32 s44, s44, 6144
    s_add_u32 s44, s44, 0x400000
    s_waitcnt lgkmcnt(0)
    s_add_u32 s24, s4, s49
    s_addc_u32 s25, s5, 0
    s_add_u32 s28, s14, s48
    s_addc_u32 s29, s15, 0
    s_add_u32 s32, s10, s49
    s_addc_u32 s33, s11, 0
    buffer_load_dwordx4 v[36:39], v14, s[24:27], 0 offen offset:0
    buffer_load_dwordx4 v[40:43], v14, s[24:27], 0 offen offset:64
    buffer_load_dwordx4 v[44:47], v14, s[24:27], 0 offen offset:128
    buffer_load_dwordx4 v[48:51], v14, s[24:27], 0 offen offset:192
    s_mov_b32 s16, s12
    s_mov_b32 s17, s13
    s_mov_b32 s18, 256
    s_mov_b32 s19, 0x20000
    s_getreg_b32 s20, hwreg(HW_REG_XCC_ID, 0, 4)
    s_or_b32 s20, s20, 128
    s_add_u32 s22, s44, 2097152
    s_lshl_b32 s23, s41, 2
    v_mov_b32 v98, 0
    v_mov_b32 v99, 140288
    s_cmp_eq_u32 s40, 0
    s_cselect_b32 s21, 64, -1
    s_cmp_eq_u32 s42, 3
    s_cselect_b32 s21, -1, s21
    v_xor_b32 v12, v2, v3
    v_lshlrev_b32 v12, 4, v12
    v_lshl_add_u32 v4, v3, 8, v12
    s_lshl_b32 s50, s40, 12
    v_add_u32 v4, s50, v4
    v_xor_b32 v5, 64, v4
    v_xor_b32 v6, 128, v4
    v_xor_b32 v7, 192, v4
    v_lshrrev_b32 v12, 2, v1
    v_bfe_u32 v13, v1, 1, 1
    s_lshl_b32 s50, s40, 2
    v_or_b32 v13, s50, v13
    v_and_b32 v10, 7, v12
    v_lshlrev_b32 v10, 1, v10
    v_xor_b32 v13, v13, v10
    v_lshlrev_b32 v13, 4, v13
    v_lshl_add_u32 v13, v12, 8, v13
    v_and_b32 v10, 1, v1
    v_lshl_add_u32 v8, v10, 3, v13
    v_xor_b32 v9, 32, v8
    v_lshlrev_b32 v17, 8, v3
    v_lshl_add_u32 v17, v2, 3, v17
    s_lshl_b32 s50, s40, 6
    v_add_u32 v17, s50, v17
    s_mov_b32 s46, 0x3e0293ee
    s_mov_b32 s50, 131072
    v_lshl_add_u32 v3, v1, 4, s50
    s_lshr_b32 s48, s40, 1
    s_lshl_b32 s48, s48, 10
    s_and_b32 s49, s40, 1
    s_lshl_b32 s49, s49, 3
    s_add_u32 s48, s48, s49
    v_add_u32 v0, s48, v3
    s_mov_b32 s50, 139264
    v_lshl_add_u32 v18, v1, 4, s50
    v_mov_b32 v2, 0x00800000
    v_mov_b32 v10, 0xff800000
    v_mov_b32 v20, 0x3f803f80
    v_mov_b32 v24, 0
    v_mov_b32 v21, 0x3f803f80
    v_mov_b32 v25, 0
    v_mov_b32 v22, 0x3f803f80
    v_mov_b32 v26, 0
    v_mov_b32 v23, 0x3f803f80
    v_mov_b32 v27, 0
    v_mov_b32 v28, 0
    v_mov_b32 v29, 0
    v_mov_b32 v30, 0
    v_mov_b32 v31, 0
    v_mov_b32 v32, 0
    v_mov_b32 v33, 0
    v_mov_b32 v34, 0
    v_mov_b32 v35, 0
    s_sub_u32 s48, s44, 18432
    s_sub_u32 s49, s44, 12288
    s_sub_u32 s50, s44, 6144
    s_waitcnt vmcnt(0)
    v_mov_b32 v56, v10
    v_mov_b32 v57, v10
    v_mov_b32 v58, v10
    v_mov_b32 v59, v10
    s_mov_b32 s43, 0
L_pass1:
    s_barrier
    ds_read_b128 v[76:79], v4 offset:0
    ds_read_b128 v[80:83], v5 offset:0
    ds_read_b128 v[84:87], v6 offset:0
    ds_read_b128 v[88:91], v7 offset:0
    s_waitcnt lgkmcnt(3)
    v_mfma_f32_16x16x32_bf16 v[52:55], v[76:79], v[36:39], 0
    s_waitcnt lgkmcnt(2)
    v_mfma_f32_16x16x32_bf16 v[52:55], v[80:83], v[40:43], v[52:55]
    s_waitcnt lgkmcnt(1)
    v_mfma_f32_16x16x32_bf16 v[52:55], v[84:87], v[44:47], v[52:55]
    s_waitcnt lgkmcnt(0)
    v_mfma_f32_16x16x32_bf16 v[52:55], v[88:91], v[48:51], v[52:55]
    v_max3_f32 v10, v56, v57, v10
    v_max3_f32 v10, v58, v59, v10
    s_set_gpr_idx_on s43, gpr_idx(DST)
    s_nop 0
    v_mov_b32 v104, v56
    v_mov_b32 v105, v57
    v_mov_b32 v106, v58
    v_mov_b32 v107, v59
    s_set_gpr_idx_off
    s_barrier
    ds_read_b128 v[76:79], v4 offset:16384
    ds_read_b128 v[80:83], v5 offset:16384
    ds_read_b128 v[84:87], v6 offset:16384
    ds_read_b128 v[88:91], v7 offset:16384
    s_waitcnt lgkmcnt(3)
    v_mfma_f32_16x16x32_bf16 v[56:59], v[76:79], v[36:39], 0
    s_waitcnt lgkmcnt(2)
    v_mfma_f32_16x16x32_bf16 v[56:59], v[80:83], v[40:43], v[56:59]
    s_waitcnt lgkmcnt(1)
    v_mfma_f32_16x16x32_bf16 v[56:59], v[84:87], v[44:47], v[56:59]
    s_waitcnt lgkmcnt(0)
    v_mfma_f32_16x16x32_bf16 v[56:59], v[88:91], v[48:51], v[56:59]
    v_max3_f32 v10, v52, v53, v10
    v_max3_f32 v10, v54, v55, v10
    s_set_gpr_idx_on s43, gpr_idx(DST)
    s_nop 0
    v_mov_b32 v108, v52
    v_mov_b32 v109, v53
    v_mov_b32 v110, v54
    v_mov_b32 v111, v55
    s_set_gpr_idx_off
    s_barrier
    ds_read_b128 v[76:79], v4 offset:32768
    ds_read_b128 v[80:83], v5 offset:32768
    ds_read_b128 v[84:87], v6 offset:32768
    ds_read_b128 v[88:91], v7 offset:32768
    s_waitcnt lgkmcnt(3)
    v_mfma_f32_16x16x32_bf16 v[52:55], v[76:79], v[36:39], 0
    s_waitcnt lgkmcnt(2)
    v_mfma_f32_16x16x32_bf16 v[52:55], v[80:83], v[40:43], v[52:55]
    s_waitcnt lgkmcnt(1)
    v_mfma_f32_16x16x32_bf16 v[52:55], v[84:87], v[44:47], v[52:55]
    s_waitcnt lgkmcnt(0)
    v_mfma_f32_16x16x32_bf16 v[52:55], v[88:91], v[48:51], v[52:55]
    v_max3_f32 v10, v56, v57, v10
    v_max3_f32 v10, v58, v59, v10
    s_set_gpr_idx_on s43, gpr_idx(DST)
    s_nop 0
    v_mov_b32 v112, v56
    v_mov_b32 v113, v57
    v_mov_b32 v114, v58
    v_mov_b32 v115, v59
    s_set_gpr_idx_off
    s_barrier
    ds_read_b128 v[76:79], v4 offset:49152
    ds_read_b128 v[80:83], v5 offset:49152
    ds_read_b128 v[84:87], v6 offset:49152
    ds_read_b128 v[88:91], v7 offset:49152
    v_xor_b32 v4, 65536, v4
    v_xor_b32 v5, 65536, v5
    v_xor_b32 v6, 65536, v6
    v_xor_b32 v7, 65536, v7
    s_waitcnt lgkmcnt(3)
    v_mfma_f32_16x16x32_bf16 v[56:59], v[76:79], v[36:39], 0
    s_waitcnt lgkmcnt(2)
    v_mfma_f32_16x16x32_bf16 v[56:59], v[80:83], v[40:43], v[56:59]
    s_waitcnt lgkmcnt(1)
    v_mfma_f32_16x16x32_bf16 v[56:59], v[84:87], v[44:47], v[56:59]
    s_waitcnt lgkmcnt(0)
    v_mfma_f32_16x16x32_bf16 v[56:59], v[88:91], v[48:51], v[56:59]
    v_max3_f32 v10, v52, v53, v10
    v_max3_f32 v10, v54, v55, v10
    s_set_gpr_idx_on s43, gpr_idx(DST)
    s_nop 0
    v_mov_b32 v116, v52
    v_mov_b32 v117, v53
    v_mov_b32 v118, v54
    v_mov_b32 v119, v55
    s_set_gpr_idx_off
    s_add_u32 s43, s43, 16
    s_cmp_lg_u32 s42, 3
    s_cbranch_scc1 L_nowait
    s_sub_u32 s22, s43, 16
    s_cmp_ge_u32 s22, 48
    s_cbranch_scc1 L_nomark
    s_mul_i32 s22, s22, 384
    s_add_u32 s22, s22, s48
    buffer_store_dwordx4 v[100:103], v15, s[28:31], s22 offen
    buffer_store_dwordx2 v[100:101], v16, s[28:31], s22 offen offset:1024
L_nomark:
    s_cmp_lg_u32 s43, 64
    s_cbranch_scc1 L_nowait
    s_waitcnt vmcnt(0)
L_nowait:
    s_cmp_lt_u32 s43, 128
    s_cbranch_scc1 L_pass1
    s_waitcnt vmcnt(0)
    v_mov_b32 v232, v56
    v_mov_b32 v233, v57
    v_mov_b32 v234, v58
    v_mov_b32 v235, v59
    s_lshl_b32 s43, s40, 2
    v_add_u32 v12, s43, v18
    v_max3_f32 v10, v232, v233, v10
    v_max3_f32 v10, v234, v235, v10
    v_mov_b32 v14, v10
    s_nop 1
    v_permlane32_swap_b32 v14, v10
    s_nop 1
    v_max_f32 v10, v14, v10
    v_mov_b32 v14, v10
    s_nop 1
    v_permlane16_swap_b32 v14, v10
    s_nop 1
    v_max_f32 v10, v14, v10
    ds_write_b32 v12, v10
    s_waitcnt lgkmcnt(0)
    s_barrier
    ds_read_b128 v[76:79], v18
    s_waitcnt lgkmcnt(0)
    v_max3_f32 v10, v76, v77, v78
    v_max_f32 v10, v10, v79
    v_mul_f32 v11, s46, v10
    v_fma_f32 v108, v108, s46, -v11
    v_fma_f32 v109, v109, s46, -v11
    v_fma_f32 v110, v110, s46, -v11
    v_fma_f32 v111, v111, s46, -v11
    v_fma_f32 v112, v112, s46, -v11
    v_fma_f32 v113, v113, s46, -v11
    v_fma_f32 v114, v114, s46, -v11
    v_fma_f32 v115, v115, s46, -v11
    v_fma_f32 v116, v116, s46, -v11
    v_fma_f32 v117, v117, s46, -v11
    v_fma_f32 v118, v118, s46, -v11
    v_fma_f32 v119, v119, s46, -v11
    v_exp_f32 v108, v108
    v_exp_f32 v109, v109
    v_exp_f32 v110, v110
    v_exp_f32 v111, v111
    v_exp_f32 v112, v112
    v_exp_f32 v113, v113
    v_exp_f32 v114, v114
    v_exp_f32 v115, v115
    v_exp_f32 v116, v116
    v_exp_f32 v117, v117
    v_exp_f32 v118, v118
    v_exp_f32 v119, v119
    s_nop 0
    v_cvt_pk_bf16_f32 v108, v108, v109
    v_cvt_pk_bf16_f32 v109, v110, v111
    ds_write_b64 v0, v[108:109] offset:0
    v_cvt_pk_bf16_f32 v112, v112, v113
    v_cvt_pk_bf16_f32 v113, v114, v115
    ds_write_b64 v0, v[112:113] offset:2048
    v_cvt_pk_bf16_f32 v116, v116, v117
    v_cvt_pk_bf16_f32 v117, v118, v119
    ds_write_b64 v0, v[116:117] offset:4096
    s_waitcnt lgkmcnt(0)
    s_barrier
    ds_read_b128 v[52:55], v3 offset:0
    ds_read_b128 v[56:59], v3 offset:1024
    ds_read_b128 v[60:63], v3 offset:2048
    ds_read_b128 v[64:67], v3 offset:3072
    ds_read_b64_tr_b16 v[76:77], v8 offset:0
    ds_read_b64_tr_b16 v[78:79], v8 offset:4096
    ds_read_b64_tr_b16 v[80:81], v9 offset:0
    ds_read_b64_tr_b16 v[82:83], v9 offset:4096
    ds_read_b64_tr_b16 v[84:85], v8 offset:8192
    ds_read_b64_tr_b16 v[86:87], v8 offset:12288
    ds_read_b64_tr_b16 v[88:89], v9 offset:8192
    ds_read_b64_tr_b16 v[90:91], v9 offset:12288
    s_waitcnt lgkmcnt(8)
    v_mfma_f32_16x16x32_bf16 v[24:27], v[20:23], v[52:55], v[24:27]
    v_mfma_f32_16x16x32_bf16 v[24:27], v[20:23], v[56:59], v[24:27]
    v_mfma_f32_16x16x32_bf16 v[24:27], v[20:23], v[60:63], v[24:27]
    v_mfma_f32_16x16x32_bf16 v[24:27], v[20:23], v[64:67], v[24:27]
    s_waitcnt lgkmcnt(0)
    ds_read_b64_tr_b16 v[92:93], v8 offset:16384
    ds_read_b64_tr_b16 v[94:95], v8 offset:20480
    ds_read_b64_tr_b16 v[96:97], v9 offset:16384
    ds_read_b64_tr_b16 v[98:99], v9 offset:20480
    ds_read_b64_tr_b16 v[100:101], v8 offset:24576
    ds_read_b64_tr_b16 v[102:103], v8 offset:28672
    ds_read_b64_tr_b16 v[104:105], v9 offset:24576
    ds_read_b64_tr_b16 v[106:107], v9 offset:28672
    v_mfma_f32_16x16x32_bf16 v[28:31], v[76:79], v[52:55], v[28:31]
    v_mfma_f32_16x16x32_bf16 v[32:35], v[80:83], v[52:55], v[32:35]
    v_mfma_f32_16x16x32_bf16 v[28:31], v[84:87], v[56:59], v[28:31]
    v_mfma_f32_16x16x32_bf16 v[32:35], v[88:91], v[56:59], v[32:35]
    v_fma_f32 v120, v120, s46, -v11
    v_fma_f32 v121, v121, s46, -v11
    v_fma_f32 v122, v122, s46, -v11
    v_fma_f32 v123, v123, s46, -v11
    v_exp_f32 v120, v120
    v_exp_f32 v121, v121
    v_exp_f32 v122, v122
    v_exp_f32 v123, v123
    s_nop 0
    v_cvt_pk_bf16_f32 v120, v120, v121
    v_cvt_pk_bf16_f32 v121, v122, v123
    ds_write_b64 v0, v[120:121] offset:6144
    ds_read_b128 v[52:55], v3 offset:4096
    ds_read_b128 v[56:59], v3 offset:5120
    s_waitcnt lgkmcnt(3)
    v_mfma_f32_16x16x32_bf16 v[28:31], v[92:95], v[60:63], v[28:31]
    v_mfma_f32_16x16x32_bf16 v[32:35], v[96:99], v[60:63], v[32:35]
    v_mfma_f32_16x16x32_bf16 v[28:31], v[100:103], v[64:67], v[28:31]
    v_mfma_f32_16x16x32_bf16 v[32:35], v[104:107], v[64:67], v[32:35]
    s_waitcnt lgkmcnt(0)
    v_mfma_f32_16x16x32_bf16 v[24:27], v[20:23], v[52:55], v[24:27]
    v_mfma_f32_16x16x32_bf16 v[24:27], v[20:23], v[56:59], v[24:27]
    s_mov_b32 s43, 0
L_pass2:
    s_barrier
    ds_read_b64_tr_b16 v[76:77], v8 offset:32768
    ds_read_b64_tr_b16 v[78:79], v8 offset:36864
    ds_read_b64_tr_b16 v[80:81], v9 offset:32768
    ds_read_b64_tr_b16 v[82:83], v9 offset:36864
    ds_read_b64_tr_b16 v[84:85], v8 offset:40960
    ds_read_b64_tr_b16 v[86:87], v8 offset:45056
    ds_read_b64_tr_b16 v[88:89], v9 offset:40960
    ds_read_b64_tr_b16 v[90:91], v9 offset:45056
    ds_read_b128 v[60:63], v3 offset:6144
    ds_read_b128 v[64:67], v3 offset:7168
    s_set_gpr_idx_on s43, gpr_idx(SRC0)
    s_nop 0
    v_fma_f32 v68, v124, s46, -v11
    v_fma_f32 v69, v125, s46, -v11
    v_fma_f32 v70, v126, s46, -v11
    v_fma_f32 v71, v127, s46, -v11
    s_set_gpr_idx_off
    v_exp_f32 v68, v68
    v_exp_f32 v69, v69
    v_exp_f32 v70, v70
    v_exp_f32 v71, v71
    s_nop 0
    v_cvt_pk_bf16_f32 v68, v68, v69
    v_cvt_pk_bf16_f32 v69, v70, v71
    ds_write_b64 v0, v[68:69] offset:0
    s_waitcnt lgkmcnt(7)
    v_mfma_f32_16x16x32_bf16 v[28:31], v[76:79], v[52:55], v[28:31]
    v_mfma_f32_16x16x32_bf16 v[32:35], v[80:83], v[52:55], v[32:35]
    s_waitcnt lgkmcnt(3)
    v_mfma_f32_16x16x32_bf16 v[28:31], v[84:87], v[56:59], v[28:31]
    v_mfma_f32_16x16x32_bf16 v[32:35], v[88:91], v[56:59], v[32:35]
    s_waitcnt lgkmcnt(0)
    v_mfma_f32_16x16x32_bf16 v[24:27], v[20:23], v[60:63], v[24:27]
    v_mfma_f32_16x16x32_bf16 v[24:27], v[20:23], v[64:67], v[24:27]
    s_barrier
    ds_read_b64_tr_b16 v[76:77], v8 offset:49152
    ds_read_b64_tr_b16 v[78:79], v8 offset:53248
    ds_read_b64_tr_b16 v[80:81], v9 offset:49152
    ds_read_b64_tr_b16 v[82:83], v9 offset:53248
    ds_read_b64_tr_b16 v[84:85], v8 offset:57344
    ds_read_b64_tr_b16 v[86:87], v8 offset:61440
    ds_read_b64_tr_b16 v[88:89], v9 offset:57344
    ds_read_b64_tr_b16 v[90:91], v9 offset:61440
    v_xor_b32 v8, 65536, v8
    v_xor_b32 v9, 65536, v9
    ds_read_b128 v[52:55], v3 offset:0
    ds_read_b128 v[56:59], v3 offset:1024
    s_set_gpr_idx_on s43, gpr_idx(SRC0)
    s_nop 0
    v_fma_f32 v68, v128, s46, -v11
    v_fma_f32 v69, v129, s46, -v11
    v_fma_f32 v70, v130, s46, -v11
    v_fma_f32 v71, v131, s46, -v11
    s_set_gpr_idx_off
    v_exp_f32 v68, v68
    v_exp_f32 v69, v69
    v_exp_f32 v70, v70
    v_exp_f32 v71, v71
    s_nop 0
    v_cvt_pk_bf16_f32 v68, v68, v69
    v_cvt_pk_bf16_f32 v69, v70, v71
    ds_write_b64 v0, v[68:69] offset:2048
    s_waitcnt lgkmcnt(7)
    v_mfma_f32_16x16x32_bf16 v[28:31], v[76:79], v[60:63], v[28:31]
    v_mfma_f32_16x16x32_bf16 v[32:35], v[80:83], v[60:63], v[32:35]
    s_waitcnt lgkmcnt(3)
    v_mfma_f32_16x16x32_bf16 v[28:31], v[84:87], v[64:67], v[28:31]
    v_mfma_f32_16x16x32_bf16 v[32:35], v[88:91], v[64:67], v[32:35]
    s_waitcnt lgkmcnt(0)
    v_mfma_f32_16x16x32_bf16 v[24:27], v[20:23], v[52:55], v[24:27]
    v_mfma_f32_16x16x32_bf16 v[24:27], v[20:23], v[56:59], v[24:27]
    s_barrier
    ds_read_b64_tr_b16 v[76:77], v8 offset:0
    ds_read_b64_tr_b16 v[78:79], v8 offset:4096
    ds_read_b64_tr_b16 v[80:81], v9 offset:0
    ds_read_b64_tr_b16 v[82:83], v9 offset:4096
    ds_read_b64_tr_b16 v[84:85], v8 offset:8192
    ds_read_b64_tr_b16 v[86:87], v8 offset:12288
    ds_read_b64_tr_b16 v[88:89], v9 offset:8192
    ds_read_b64_tr_b16 v[90:91], v9 offset:12288
    ds_read_b128 v[60:63], v3 offset:2048
    ds_read_b128 v[64:67], v3 offset:3072
    s_set_gpr_idx_on s43, gpr_idx(SRC0)
    s_nop 0
    v_fma_f32 v68, v132, s46, -v11
    v_fma_f32 v69, v133, s46, -v11
    v_fma_f32 v70, v134, s46, -v11
    v_fma_f32 v71, v135, s46, -v11
    s_set_gpr_idx_off
    v_exp_f32 v68, v68
    v_exp_f32 v69, v69
    v_exp_f32 v70, v70
    v_exp_f32 v71, v71
    s_nop 0
    v_cvt_pk_bf16_f32 v68, v68, v69
    v_cvt_pk_bf16_f32 v69, v70, v71
    ds_write_b64 v0, v[68:69] offset:4096
    s_waitcnt lgkmcnt(7)
    v_mfma_f32_16x16x32_bf16 v[28:31], v[76:79], v[52:55], v[28:31]
    v_mfma_f32_16x16x32_bf16 v[32:35], v[80:83], v[52:55], v[32:35]
    s_waitcnt lgkmcnt(3)
    v_mfma_f32_16x16x32_bf16 v[28:31], v[84:87], v[56:59], v[28:31]
    v_mfma_f32_16x16x32_bf16 v[32:35], v[88:91], v[56:59], v[32:35]
    s_waitcnt lgkmcnt(0)
    v_mfma_f32_16x16x32_bf16 v[24:27], v[20:23], v[60:63], v[24:27]
    v_mfma_f32_16x16x32_bf16 v[24:27], v[20:23], v[64:67], v[24:27]
    s_barrier
    ds_read_b64_tr_b16 v[76:77], v8 offset:16384
    ds_read_b64_tr_b16 v[78:79], v8 offset:20480
    ds_read_b64_tr_b16 v[80:81], v9 offset:16384
    ds_read_b64_tr_b16 v[82:83], v9 offset:20480
    ds_read_b64_tr_b16 v[84:85], v8 offset:24576
    ds_read_b64_tr_b16 v[86:87], v8 offset:28672
    ds_read_b64_tr_b16 v[88:89], v9 offset:24576
    ds_read_b64_tr_b16 v[90:91], v9 offset:28672
    ds_read_b128 v[52:55], v3 offset:4096
    ds_read_b128 v[56:59], v3 offset:5120
    s_set_gpr_idx_on s43, gpr_idx(SRC0)
    s_nop 0
    v_fma_f32 v68, v136, s46, -v11
    v_fma_f32 v69, v137, s46, -v11
    v_fma_f32 v70, v138, s46, -v11
    v_fma_f32 v71, v139, s46, -v11
    s_set_gpr_idx_off
    v_exp_f32 v68, v68
    v_exp_f32 v69, v69
    v_exp_f32 v70, v70
    v_exp_f32 v71, v71
    s_nop 0
    v_cvt_pk_bf16_f32 v68, v68, v69
    v_cvt_pk_bf16_f32 v69, v70, v71
    ds_write_b64 v0, v[68:69] offset:6144
    s_waitcnt lgkmcnt(7)
    v_mfma_f32_16x16x32_bf16 v[28:31], v[76:79], v[60:63], v[28:31]
    v_mfma_f32_16x16x32_bf16 v[32:35], v[80:83], v[60:63], v[32:35]
    s_waitcnt lgkmcnt(3)
    v_mfma_f32_16x16x32_bf16 v[28:31], v[84:87], v[64:67], v[28:31]
    v_mfma_f32_16x16x32_bf16 v[32:35], v[88:91], v[64:67], v[32:35]
    s_waitcnt lgkmcnt(0)
    v_mfma_f32_16x16x32_bf16 v[24:27], v[20:23], v[52:55], v[24:27]
    v_mfma_f32_16x16x32_bf16 v[24:27], v[20:23], v[56:59], v[24:27]
    s_add_u32 s43, s43, 16
    s_sub_u32 s52, s43, s21
    s_cmp_lg_u32 s52, 0
    s_cbranch_scc1 L_noask
    buffer_load_dword v98, off, s[16:19], s23 sc1
L_noask:
    s_cmp_lg_u32 s52, 32
    s_cbranch_scc1 L_noshare
    v_mov_b32 v99, 140288
    s_waitcnt vmcnt(0)
    ds_write_b32 v99, v98
L_noshare:
    s_cmp_lt_u32 s43, 112
    s_cbranch_scc1 L_pass2
    v_mov_b32 v14, 140288
    s_barrier
    ds_read_u8 v14, v14
    ds_read_b64_tr_b16 v[76:77], v8 offset:32768
    ds_read_b64_tr_b16 v[78:79], v8 offset:36864
    ds_read_b64_tr_b16 v[80:81], v9 offset:32768
    ds_read_b64_tr_b16 v[82:83], v9 offset:36864
    ds_read_b64_tr_b16 v[84:85], v8 offset:40960
    ds_read_b64_tr_b16 v[86:87], v8 offset:45056
    ds_read_b64_tr_b16 v[88:89], v9 offset:40960
    ds_read_b64_tr_b16 v[90:91], v9 offset:45056
    ds_read_b128 v[60:63], v3 offset:6144
    ds_read_b128 v[64:67], v3 offset:7168
    s_waitcnt lgkmcnt(6)
    v_mfma_f32_16x16x32_bf16 v[28:31], v[76:79], v[52:55], v[28:31]
    v_mfma_f32_16x16x32_bf16 v[32:35], v[80:83], v[52:55], v[32:35]
    s_waitcnt lgkmcnt(2)
    v_mfma_f32_16x16x32_bf16 v[28:31], v[84:87], v[56:59], v[28:31]
    v_mfma_f32_16x16x32_bf16 v[32:35], v[88:91], v[56:59], v[32:35]
    s_waitcnt lgkmcnt(0)
    v_mfma_f32_16x16x32_bf16 v[24:27], v[20:23], v[60:63], v[24:27]
    v_mfma_f32_16x16x32_bf16 v[24:27], v[20:23], v[64:67], v[24:27]
    v_readfirstlane_b32 s21, v14
    s_mov_b32 s52, s42
    s_nop 6
    v_log_f32 v13, v24
    v_rcp_f32 v24, v24
    s_add_u32 s57, s56, 0x8000
    v_add_f32 v13, v11, v13
    s_cmp_eq_u32 s52, 3
    s_cbranch_scc1 L_gather
    s_barrier
    ds_read_b64_tr_b16 v[76:77], v8 offset:49152
    ds_read_b64_tr_b16 v[78:79], v8 offset:53248
    ds_read_b64_tr_b16 v[80:81], v9 offset:49152
    ds_read_b64_tr_b16 v[82:83], v9 offset:53248
    ds_read_b64_tr_b16 v[84:85], v8 offset:57344
    ds_read_b64_tr_b16 v[86:87], v8 offset:61440
    ds_read_b64_tr_b16 v[88:89], v9 offset:57344
    ds_read_b64_tr_b16 v[90:91], v9 offset:61440
    v_xor_b32 v8, 65536, v8
    v_xor_b32 v9, 65536, v9
    s_waitcnt lgkmcnt(4)
    v_mfma_f32_16x16x32_bf16 v[28:31], v[76:79], v[60:63], v[28:31]
    v_mfma_f32_16x16x32_bf16 v[32:35], v[80:83], v[60:63], v[32:35]
    s_waitcnt lgkmcnt(0)
    v_mfma_f32_16x16x32_bf16 v[28:31], v[84:87], v[64:67], v[28:31]
    v_mfma_f32_16x16x32_bf16 v[32:35], v[88:91], v[64:67], v[32:35]
    v_max_i32 v13, s57, v13
    v_mul_f32 v24, 0x38000100, v24
    s_nop 4
    v_max3_f32 v12, abs(v28), abs(v29), abs(v30)
    v_max3_f32 v14, abs(v32), abs(v33), abs(v34)
    v_max3_f32 v12, abs(v31), abs(v35), v12
    v_max3_f32 v12, v12, v14, v2
    v_rcp_f32 v14, v12
    s_nop 0
    v_mul_f32 v108, v14, v28
    v_mul_f32 v109, v14, v29
    v_mul_f32 v110, v14, v30
    v_mul_f32 v111, v14, v31
    v_mul_f32 v112, v14, v32
    v_mul_f32 v113, v14, v33
    v_mul_f32 v114, v14, v34
    v_mul_f32 v115, v14, v35
    v_cvt_pknorm_i16_f32 v20, v108, v109
    v_cvt_pknorm_i16_f32 v21, v110, v111
    v_cvt_pknorm_i16_f32 v22, v112, v113
    v_cvt_pknorm_i16_f32 v23, v114, v115
    s_cmp_eq_u32 s21, s20
    s_cbranch_scc1 L_near1
    buffer_store_dwordx4 v[20:23], v15, s[28:31], s22 offen sc1
    s_branch L_stored1
L_near1:
    buffer_store_dwordx4 v[20:23], v15, s[28:31], s44 offen
L_stored1:
    v_add_f32 v10, v108, v109
    v_add_f32 v14, v110, v111
    v_add_f32 v10, v10, v112
    v_add_f32 v14, v14, v113
    v_add_f32 v10, v10, v114
    v_add_f32 v14, v14, v115
    v_mul_f32 v12, v12, v24
    v_add_f32 v10, v10, v14
    v_fma_f32 v12, v10, 0, v12
    v_max_i32 v12, s57, v12
    s_cmp_eq_u32 s21, s20
    s_cbranch_scc1 L_near2
    buffer_store_dwordx2 v[12:13], v16, s[28:31], s22 offen offset:1024 sc1
    s_lshl_b32 s48, s41, 2
    s_add_u32 s12, s12, s48
    s_addc_u32 s13, s13, 0
    s_lshl2_add_u32 s49, s42, s40
    s_lshl_b32 s49, 0x100, s49
    s_waitcnt vmcnt(0)
    s_atomic_add s49, s[12:13], 0 glc
    s_waitcnt lgkmcnt(0)
    s_branch L_stored2
L_near2:
    buffer_store_dwordx2 v[12:13], v16, s[28:31], s44 offen offset:1024
L_stored2:
    s_branch L_fin
L_gather:
    s_mov_b32 s43, 0x40000
    buffer_load_dwordx4 v[140:143], v15, s[28:31], s48 offen sc1
    buffer_load_dwordx2 v[156:157], v16, s[28:31], s48 offen offset:1024 sc1
    buffer_load_dwordx4 v[144:147], v15, s[28:31], s49 offen sc1
    buffer_load_dwordx2 v[158:159], v16, s[28:31], s49 offen offset:1024 sc1
    buffer_load_dwordx4 v[148:151], v15, s[28:31], s50 offen sc1
    buffer_load_dwordx2 v[160:161], v16, s[28:31], s50 offen offset:1024 sc1
    s_barrier
    ds_read_b64_tr_b16 v[76:77], v8 offset:49152
    ds_read_b64_tr_b16 v[78:79], v8 offset:53248
    ds_read_b64_tr_b16 v[80:81], v9 offset:49152
    ds_read_b64_tr_b16 v[82:83], v9 offset:53248
    ds_read_b64_tr_b16 v[84:85], v8 offset:57344
    ds_read_b64_tr_b16 v[86:87], v8 offset:61440
    ds_read_b64_tr_b16 v[88:89], v9 offset:57344
    ds_read_b64_tr_b16 v[90:91], v9 offset:61440
    v_xor_b32 v8, 65536, v8
    v_xor_b32 v9, 65536, v9
    s_waitcnt lgkmcnt(4)
    v_mfma_f32_16x16x32_bf16 v[28:31], v[76:79], v[60:63], v[28:31]
    v_mfma_f32_16x16x32_bf16 v[32:35], v[80:83], v[60:63], v[32:35]
    s_waitcnt lgkmcnt(0)
    v_mfma_f32_16x16x32_bf16 v[28:31], v[84:87], v[64:67], v[28:31]
    v_mfma_f32_16x16x32_bf16 v[32:35], v[88:91], v[64:67], v[32:35]
    s_branch L_check
L_poll:
    s_and_b32 s21, s43, 15
    s_cbranch_scc1 L_poll2
    buffer_load_dword v14, off, s[16:19], s23 sc1
    s_add_u32 s20, s40, 8
    s_waitcnt vmcnt(0)
    v_readfirstlane_b32 s21, v14
    s_nop 0
    s_lshr_b32 s21, s21, s20
    s_and_b32 s21, s21, 0x111
    s_cbranch_scc0 L_poll2
    s_bfe_u32 s20, s21, 0x10000
    s_lshl_b32 s20, s20, 21
    s_or_b32 s48, s48, s20
    s_bfe_u32 s20, s21, 0x10004
    s_lshl_b32 s20, s20, 21
    s_or_b32 s49, s49, s20
    s_bfe_u32 s20, s21, 0x10008
    s_lshl_b32 s20, s20, 21
    s_or_b32 s50, s50, s20
    buffer_inv sc1
    s_waitcnt vmcnt(0)
L_poll2:
    s_cmp_eq_u64 s[66:67], 0
    s_cbranch_scc1 L_have0
    buffer_load_dwordx4 v[140:143], v15, s[28:31], s48 offen sc1
    buffer_load_dwordx2 v[156:157], v16, s[28:31], s48 offen offset:1024 sc1
L_have0:
    s_cmp_eq_u64 s[68:69], 0
    s_cbranch_scc1 L_have1
    buffer_load_dwordx4 v[144:147], v15, s[28:31], s49 offen sc1
    buffer_load_dwordx2 v[158:159], v16, s[28:31], s49 offen offset:1024 sc1
L_have1:
    s_cmp_eq_u64 s[70:71], 0
    s_cbranch_scc1 L_have2
    buffer_load_dwordx4 v[148:151], v15, s[28:31], s50 offen sc1
    buffer_load_dwordx2 v[160:161], v16, s[28:31], s50 offen offset:1024 sc1
L_have2:
L_check:
    s_sub_u32 s43, s43, 1
    s_cbranch_scc1 L_fin
    s_waitcnt vmcnt(0)
    v_min3_i32 v108, v140, v141, v142
    v_min3_i32 v112, v143, v156, v157
    v_min3_i32 v109, v144, v145, v146
    v_min3_i32 v113, v147, v158, v159
    v_min3_i32 v110, v148, v149, v150
    v_min3_i32 v114, v151, v160, v161
    v_min_i32 v108, v108, v112
    v_min_i32 v109, v109, v113
    v_min_i32 v110, v110, v114
    v_cmp_eq_u32 s[66:67], s56, v108
    v_cmp_eq_u32 s[68:69], s56, v109
    v_cmp_eq_u32 s[70:71], s56, v110
    v_max3_f32 v10, v157, v159, v161
    v_max_f32 v10, v10, v13
    s_or_b64 vcc, s[66:67], s[68:69]
    s_or_b64 vcc, vcc, s[70:71]
    s_cbranch_scc1 L_poll
    v_sub_f32 v13, v13, v10
    v_sub_f32 v157, v157, v10
    v_sub_f32 v159, v159, v10
    v_sub_f32 v161, v161, v10
    v_exp_f32 v13, v13
    v_exp_f32 v157, v157
    v_exp_f32 v159, v159
    v_exp_f32 v161, v161
    v_cvt_f32_i32_sdwa v108, sext(v140) dst_sel:DWORD dst_unused:UNUSED_PAD src0_sel:WORD_0
    v_cvt_f32_i32_sdwa v109, sext(v140) dst_sel:DWORD dst_unused:UNUSED_PAD src0_sel:WORD_1
    v_cvt_f32_i32_sdwa v110, sext(v141) dst_sel:DWORD dst_unused:UNUSED_PAD src0_sel:WORD_0
    v_cvt_f32_i32_sdwa v111, sext(v141) dst_sel:DWORD dst_unused:UNUSED_PAD src0_sel:WORD_1
    v_cvt_f32_i32_sdwa v112, sext(v142) dst_sel:DWORD dst_unused:UNUSED_PAD src0_sel:WORD_0
    v_cvt_f32_i32_sdwa v113, sext(v142) dst_sel:DWORD dst_unused:UNUSED_PAD src0_sel:WORD_1
    v_cvt_f32_i32_sdwa v114, sext(v143) dst_sel:DWORD dst_unused:UNUSED_PAD src0_sel:WORD_0
    v_cvt_f32_i32_sdwa v115, sext(v143) dst_sel:DWORD dst_unused:UNUSED_PAD src0_sel:WORD_1
    v_add_f32 v10, v13, v157
    v_add_f32 v14, v159, v161
    v_add_f32 v10, v10, v14
    v_rcp_f32 v10, v10
    v_mul_f32 v13, v13, v24
    v_mul_f32 v156, v156, v157
    v_mul_f32 v158, v158, v159
    v_mul_f32 v160, v160, v161
    v_cvt_f32_i32_sdwa v116, sext(v144) dst_sel:DWORD dst_unused:UNUSED_PAD src0_sel:WORD_0
    v_cvt_f32_i32_sdwa v117, sext(v144) dst_sel:DWORD dst_unused:UNUSED_PAD src0_sel:WORD_1
    v_cvt_f32_i32_sdwa v118, sext(v145) dst_sel:DWORD dst_unused:UNUSED_PAD src0_sel:WORD_0
    v_cvt_f32_i32_sdwa v119, sext(v145) dst_sel:DWORD dst_unused:UNUSED_PAD src0_sel:WORD_1
    v_cvt_f32_i32_sdwa v120, sext(v146) dst_sel:DWORD dst_unused:UNUSED_PAD src0_sel:WORD_0
    v_cvt_f32_i32_sdwa v121, sext(v146) dst_sel:DWORD dst_unused:UNUSED_PAD src0_sel:WORD_1
    v_cvt_f32_i32_sdwa v122, sext(v147) dst_sel:DWORD dst_unused:UNUSED_PAD src0_sel:WORD_0
    v_cvt_f32_i32_sdwa v123, sext(v147) dst_sel:DWORD dst_unused:UNUSED_PAD src0_sel:WORD_1
    v_cvt_f32_i32_sdwa v124, sext(v148) dst_sel:DWORD dst_unused:UNUSED_PAD src0_sel:WORD_0
    v_cvt_f32_i32_sdwa v125, sext(v148) dst_sel:DWORD dst_unused:UNUSED_PAD src0_sel:WORD_1
    v_cvt_f32_i32_sdwa v126, sext(v149) dst_sel:DWORD dst_unused:UNUSED_PAD src0_sel:WORD_0
    v_cvt_f32_i32_sdwa v127, sext(v149) dst_sel:DWORD dst_unused:UNUSED_PAD src0_sel:WORD_1
    v_cvt_f32_i32_sdwa v128, sext(v150) dst_sel:DWORD dst_unused:UNUSED_PAD src0_sel:WORD_0
    v_cvt_f32_i32_sdwa v129, sext(v150) dst_sel:DWORD dst_unused:UNUSED_PAD src0_sel:WORD_1
    v_cvt_f32_i32_sdwa v130, sext(v151) dst_sel:DWORD dst_unused:UNUSED_PAD src0_sel:WORD_0
    v_cvt_f32_i32_sdwa v131, sext(v151) dst_sel:DWORD dst_unused:UNUSED_PAD src0_sel:WORD_1
    v_mul_f32 v28, v13, v28
    v_mul_f32 v29, v13, v29
    v_mul_f32 v30, v13, v30
    v_mul_f32 v31, v13, v31
    v_mul_f32 v32, v13, v32
    v_mul_f32 v33, v13, v33
    v_mul_f32 v34, v13, v34
    v_mul_f32 v35, v13, v35
    v_fmac_f32 v28, v156, v108
    v_fmac_f32 v29, v156, v109
    v_fmac_f32 v30, v156, v110
    v_fmac_f32 v31, v156, v111
    v_fmac_f32 v32, v156, v112
    v_fmac_f32 v33, v156, v113
    v_fmac_f32 v34, v156, v114
    v_fmac_f32 v35, v156, v115
    v_fmac_f32 v28, v158, v116
    v_fmac_f32 v29, v158, v117
    v_fmac_f32 v30, v158, v118
    v_fmac_f32 v31, v158, v119
    v_fmac_f32 v32, v158, v120
    v_fmac_f32 v33, v158, v121
    v_fmac_f32 v34, v158, v122
    v_fmac_f32 v35, v158, v123
    v_fmac_f32 v28, v160, v124
    v_fmac_f32 v29, v160, v125
    v_fmac_f32 v30, v160, v126
    v_fmac_f32 v31, v160, v127
    v_fmac_f32 v32, v160, v128
    v_fmac_f32 v33, v160, v129
    v_fmac_f32 v34, v160, v130
    v_fmac_f32 v35, v160, v131
    v_mul_f32 v28, v10, v28
    v_mul_f32 v29, v10, v29
    v_mul_f32 v30, v10, v30
    v_mul_f32 v31, v10, v31
    v_mul_f32 v32, v10, v32
    v_mul_f32 v33, v10, v33
    v_mul_f32 v34, v10, v34
    v_mul_f32 v35, v10, v35
    v_cvt_pk_bf16_f32 v20, v28, v29
    v_cvt_pk_bf16_f32 v21, v30, v31
    v_cvt_pk_bf16_f32 v22, v32, v33
    v_cvt_pk_bf16_f32 v23, v34, v35
    buffer_store_dwordx2 v[20:21], v17, s[32:35], 0 offen
    buffer_store_dwordx2 v[22:23], v17, s[32:35], 0 offen offset:32
L_fin:
L_end:
    s_endpgm
.section .rodata,"a"
.p2align 6
.amdhsa_kernel standalone__gqa_softmax__sampling_kernel
  .amdhsa_next_free_vgpr 236
  .amdhsa_next_free_sgpr 72
  .amdhsa_accum_offset 236
  .amdhsa_group_segment_fixed_size 0
  .amdhsa_kernarg_size 48
  .amdhsa_user_sgpr_count 2
  .amdhsa_user_sgpr_kernarg_segment_ptr 1
  .amdhsa_system_sgpr_workgroup_id_x 1
.end_amdhsa_kernel
```
